```python
import torch

def _softmax(x, axis=-1):
    return torch.softmax(x, dim=axis)
def _gelu(x):
    return torch.nn.functional.gelu(x, approximate="tanh")
def _silu(x):
    return torch.nn.functional.silu(x)
def _sigmoid(x):
    return torch.sigmoid(x)
def _layernorm(x, axis=-1, eps=1e-5):
    m = x.mean(dim=axis, keepdim=True)
    v = x.var(dim=axis, keepdim=True, unbiased=False)
    return (x - m) / torch.sqrt(v + eps)
def _scatter_add(tgt, idx, src, axis=0):
    return tgt.clone().index_add_(axis, idx, src)
def _segment_sum(src, seg, n):
    out = torch.zeros((n,) + src.shape[1:], dtype=src.dtype)
    return out.index_add_(0, seg, src)
def _pad(x, pw):
    flat = tuple(v for pair in reversed(pw) for v in pair)
    return torch.nn.functional.pad(x, flat)

kernel_name = 'standalone__kernel_systems_refs_featgraph__graph'

def setup_inputs():

    _w = (lambda a: (lambda t: t.to(torch.bfloat16) if t.is_floating_point() else t)(torch.as_tensor(a)))
    N, deg, D = 25000, 16, 128
    E = N * deg
    scale = D ** -0.5
    src = (lambda lo, hi, *s: torch.randint(lo, hi, s))(0, N, E).to(torch.int64)
    dst = (lambda lo, hi, *s: torch.randint(lo, hi, s))(0, N, E).to(torch.int64)
    return {
        "x": _w((lambda *s: torch.randn(*s, dtype=torch.bfloat16) * 0.8)(N, D)),
        "src": _w(src),
        "dst": _w(dst),
        "w_q": _w((lambda *s: torch.randn(*s, dtype=torch.bfloat16) * 0.8)(D, D) * scale),
        "w_v": _w((lambda *s: torch.randn(*s, dtype=torch.bfloat16) * 0.05)(D, D) * scale),
    }

def reference(x, src, dst, w_q, w_v):
    N, D = x.shape
    xs = x[src]
    xd = x[dst]
    q = xd @ w_q
    logits = torch.einsum('ed,ed->e', xs, q) * (float(D) ** -0.5)
    alpha = _sigmoid(logits)
    msg = alpha[:, None] * (xs @ w_v)
    return _segment_sum(msg, dst, N)
```

```asm
; @launch grid=(256,1,1) block=(512,1,1) lds=149504
.amdgcn_target "amdgcn-amd-amdhsa--gfx950"
.text
.globl standalone__kernel_systems_refs_featgraph__graph_kernel
.p2align 8
.type standalone__kernel_systems_refs_featgraph__graph_kernel,@function
standalone__kernel_systems_refs_featgraph__graph_kernel:
    s_cmp_ge_u32 s2, 256
    s_cbranch_scc1 L_end
    s_load_dwordx16 s[24:39], s[0:1], 0
    v_lshrrev_b32 v1, 6, v0
    v_lshlrev_b32 v23, 4, v0
    v_readfirstlane_b32 s3, v1
    v_mov_b32 v236, 0
    v_mov_b32 v237, 0
    v_mov_b32 v238, 0
    v_mov_b32 v239, 0
    v_cmp_gt_u32 vcc, 64, v0
    s_and_saveexec_b64 s[54:55], vcc
    ds_write_b128 v23, v[236:239] offset:16384
    v_cmpx_gt_u32 vcc, 9, v0
    ds_write_b128 v23, v[236:239] offset:17408
    s_mov_b64 exec, s[54:55]
    s_lshr_b32 s56, s2, 3
    s_bfe_u32 s43, s2, 0x10003
    s_and_b32 s57, s2, 7
    s_lshr_b32 s58, s2, 4
    s_lshl_b32 s58, s58, 3
    s_and_b32 s57, s2, 7
    s_lshl_b32 s57, s57, 4
    s_lshr_b32 s58, s2, 4
    s_or_b32 s57, s57, s58
    s_and_b32 s2, s2, 7
    s_lshl_b32 s2, s2, 5
    s_or_b32 s2, s2, s56
    v_add_u32 v1, 116736, v23
    s_cmp_lg_u32 s43, 0
    s_cbranch_scc1 L_nz
    ds_write_b128 v1, v[236:239] offset:0
    ds_write_b128 v1, v[236:239] offset:8192
    ds_write_b128 v1, v[236:239] offset:16384
    ds_write_b128 v1, v[236:239] offset:24576
L_nz:
    v_and_b32 v28, 15, v0
    v_bfe_u32 v29, v0, 4, 2
    v_and_b32 v30, 63, v0
    v_mov_b32 v22, 0
    s_mov_b32 s41, 14336
    s_mov_b32 s40, 0x7fff00
    s_lshl_b32 s42, s3, 14
    s_add_u32 s42, s42, 18432
    s_mul_i32 s58, s57, 12512
    s_mov_b32 s59, 391
    s_cmp_eq_u32 s57, 127
    s_cselect_b32 s59, 343, s59
    s_waitcnt lgkmcnt(0)
    s_mov_b32 s12, s26
    s_and_b32 s13, s27, 0xffff
    s_mov_b32 s14, 1600000
    s_mov_b32 s15, 0x20000
    s_mov_b32 s20, s28
    s_and_b32 s21, s29, 0xffff
    s_mov_b32 s22, 1600000
    s_mov_b32 s23, 0x20000
    s_mov_b32 s16, s36
    s_and_b32 s17, s37, 0xffff
    s_mov_b32 s18, 256
    s_mov_b32 s19, 0x20000
    s_cmp_lg_u32 s43, 0
    s_cbranch_scc1 L_noedge
    v_cmp_gt_u32 vcc, s59, v0
    s_and_saveexec_b64 s[54:55], vcc
    s_cbranch_execz L_noedge0
    v_lshlrev_b32 v236, 5, v0
    buffer_load_dwordx4 v[104:107], v236, s[20:23], s58 offen
    buffer_load_dwordx4 v[108:111], v236, s[20:23], s58 offen offset:16
    buffer_load_dwordx4 v[96:99], v236, s[12:15], s58 offen
    buffer_load_dwordx4 v[100:103], v236, s[12:15], s58 offen offset:16
    s_mov_b32 s8, s38
    s_and_b32 s9, s39, 0xffff
    s_mov_b32 s10, 16384
    s_mov_b32 s11, 0x20000
    s_lshl_b32 s46, s57, 7
    buffer_load_dwordx2 v[144:145], v22, s[8:11], s46 offen sc0 sc1
L_noedge0:
    s_mov_b64 exec, s[54:55]
L_noedge:
    s_mov_b32 s4, s24
    s_and_b32 s5, s25, 0xffff
    s_mov_b32 s6, 6400000
    s_mov_b32 s7, 0x20000
    s_cmp_lg_u32 s43, 0
    s_cbranch_scc1 L_nob1
    s_barrier
L_nob1:
    s_cmp_lt_u32 s3, 6
    s_cbranch_scc1 L_nodma
    v_lshlrev_b32 v1, 1, v29
    v_xor_b32 v1, v1, v28
    v_lshlrev_b32 v1, 4, v1
    s_add_u32 s46, s3, s43
    s_cmp_eq_u32 s46, 6
    s_cbranch_scc1 L_nodma
    s_cmp_eq_u32 s46, 8
    s_cbranch_scc1 L_wdma
    v_lshl_add_u32 v160, v29, 19, v1
    s_lshl_b32 s47, s2, 8
    v_add_u32 v160, s47, v160
    v_add_u32 v161, 2096128, v160
    v_xor_b32 v161, 128, v161
    v_add_u32 v162, 4192256, v160
    v_add_u32 v163, 6288384, v160
    v_xor_b32 v163, 128, v163
    s_mov_b32 m0, 83968
    s_mov_b32 s46, 8
L_xl:
    buffer_load_dwordx4 v160, s[4:7], 0 offen offset:0 lds
    buffer_load_dwordx4 v161, s[4:7], 0 offen offset:1024 lds
    buffer_load_dwordx4 v162, s[4:7], 0 offen offset:2048 lds
    buffer_load_dwordx4 v163, s[4:7], 0 offen offset:3072 lds
    v_add_u32 v160, 0x10000, v160
    v_add_u32 v161, 0x10000, v161
    v_add_u32 v162, 0x10000, v162
    v_add_u32 v163, 0x10000, v163
    s_add_u32 m0, m0, 4096
    s_sub_u32 s46, s46, 1
    s_cmp_lg_u32 s46, 0
    s_cbranch_scc1 L_xl
    s_cmp_eq_u32 s3, 6
    s_cbranch_scc1 L_nodma
L_spin7:
    ds_read_b32 v2, v22 offset:17536
    s_waitcnt lgkmcnt(0)
    v_readfirstlane_b32 s50, v2
    s_cmp_lt_u32 s50, 9
    s_cbranch_scc1 L_spin7
L_wdma:
    v_lshl_add_u32 v2, v29, 8, v1
    v_xor_b32 v3, 128, v2
    s_mov_b32 s8, s30
    s_and_b32 s9, s31, 0xffff
    s_mov_b32 s10, 32768
    s_mov_b32 s11, 0x20000
    s_lshl_b32 s46, s56, 12
    s_mov_b32 s47, 8
L_wl0:
    s_and_b32 s46, s46, 0x7000
    s_add_u32 m0, s46, 18432
    s_sub_u32 s47, s47, 1
    buffer_load_dwordx4 v2, s[8:11], s46 offen offset:0 lds
    buffer_load_dwordx4 v2, s[8:11], s46 offen offset:1024 lds
    buffer_load_dwordx4 v3, s[8:11], s46 offen offset:2048 lds
    buffer_load_dwordx4 v3, s[8:11], s46 offen offset:3072 lds
    s_add_u32 s46, s46, 4096
    s_cmp_lg_u32 s47, 0
    s_cbranch_scc1 L_wl0
    s_branch L_tagd
L_nodma:
    s_cmp_eq_u32 s43, 0
    s_cbranch_scc1 L_prod
    s_branch L_tag
L_prod:
    s_setprio 2
    v_cmp_gt_u32 vcc, s59, v0
    s_and_saveexec_b64 s[54:55], vcc
    s_cbranch_execz L_binned
    s_waitcnt vmcnt(3)
    s_mov_b32 s46, 0x3fc
    v_mov_b32 v1, 1
    v_lshlrev_b32 v120, 2, v104
    v_and_b32 v120, s46, v120
    ds_add_rtn_u32 v112, v120, v1 offset:16384
    v_lshlrev_b32 v121, 2, v105
    v_and_b32 v121, s46, v121
    ds_add_rtn_u32 v113, v121, v1 offset:16384
    v_lshlrev_b32 v122, 2, v106
    v_and_b32 v122, s46, v122
    ds_add_rtn_u32 v114, v122, v1 offset:16384
    v_lshlrev_b32 v123, 2, v107
    v_and_b32 v123, s46, v123
    ds_add_rtn_u32 v115, v123, v1 offset:16384
    v_lshlrev_b32 v124, 2, v108
    v_and_b32 v124, s46, v124
    ds_add_rtn_u32 v116, v124, v1 offset:16384
    v_lshlrev_b32 v125, 2, v109
    v_and_b32 v125, s46, v125
    ds_add_rtn_u32 v117, v125, v1 offset:16384
    v_lshlrev_b32 v126, 2, v110
    v_and_b32 v126, s46, v126
    ds_add_rtn_u32 v118, v126, v1 offset:16384
    v_lshlrev_b32 v127, 2, v111
    v_and_b32 v127, s46, v127
    ds_add_rtn_u32 v119, v127, v1 offset:16384
    s_waitcnt vmcnt(1)
    v_mov_b32 v237, 0x81
    v_cmp_le_u32 s[60:61], s41, v96
    v_cmp_le_u32 s[62:63], s41, v97
    v_cmp_le_u32 s[64:65], s41, v98
    v_cmp_le_u32 s[66:67], s41, v99
    v_cmp_le_u32 s[68:69], s41, v100
    v_cmp_le_u32 s[70:71], s41, v101
    v_cmp_le_u32 s[72:73], s41, v102
    v_cmp_le_u32 s[74:75], s41, v103
    v_lshrrev_b32 v238, 4, v104
    v_and_b32 v238, 0x70, v238
    v_lshl_or_b32 v228, v96, 8, v238
    v_lshrrev_b32 v238, 11, v104
    v_cndmask_b32 v239, 1, v237, s[60:61]
    v_add3_u32 v228, v228, v238, v239
    v_lshrrev_b32 v238, 4, v105
    v_and_b32 v238, 0x70, v238
    v_lshl_or_b32 v229, v97, 8, v238
    v_lshrrev_b32 v238, 11, v105
    v_cndmask_b32 v239, 1, v237, s[62:63]
    v_add3_u32 v229, v229, v238, v239
    v_lshrrev_b32 v238, 4, v106
    v_and_b32 v238, 0x70, v238
    v_lshl_or_b32 v230, v98, 8, v238
    v_lshrrev_b32 v238, 11, v106
    v_cndmask_b32 v239, 1, v237, s[64:65]
    v_add3_u32 v230, v230, v238, v239
    v_lshrrev_b32 v238, 4, v107
    v_and_b32 v238, 0x70, v238
    v_lshl_or_b32 v231, v99, 8, v238
    v_lshrrev_b32 v238, 11, v107
    v_cndmask_b32 v239, 1, v237, s[66:67]
    v_add3_u32 v231, v231, v238, v239
    v_lshrrev_b32 v238, 4, v108
    v_and_b32 v238, 0x70, v238
    v_lshl_or_b32 v232, v100, 8, v238
    v_lshrrev_b32 v238, 11, v108
    v_cndmask_b32 v239, 1, v237, s[68:69]
    v_add3_u32 v232, v232, v238, v239
    v_lshrrev_b32 v238, 4, v109
    v_and_b32 v238, 0x70, v238
    v_lshl_or_b32 v233, v101, 8, v238
    v_lshrrev_b32 v238, 11, v109
    v_cndmask_b32 v239, 1, v237, s[70:71]
    v_add3_u32 v233, v233, v238, v239
    v_lshrrev_b32 v238, 4, v110
    v_and_b32 v238, 0x70, v238
    v_lshl_or_b32 v234, v102, 8, v238
    v_lshrrev_b32 v238, 11, v110
    v_cndmask_b32 v239, 1, v237, s[72:73]
    v_add3_u32 v234, v234, v238, v239
    v_lshrrev_b32 v238, 4, v111
    v_and_b32 v238, 0x70, v238
    v_lshl_or_b32 v235, v103, 8, v238
    v_lshrrev_b32 v238, 11, v111
    v_cndmask_b32 v239, 1, v237, s[74:75]
    v_add3_u32 v235, v235, v238, v239
    s_mov_b64 s[76:77], exec
    s_waitcnt vmcnt(0)
    v_readfirstlane_b32 s48, v144
    v_readfirstlane_b32 s49, v145
    s_lshr_b32 s48, s48, 23
    s_lshr_b32 s49, s49, 26
    s_lshl_b32 s49, s49, 9
    s_or_b32 s48, s48, s49
    s_add_u32 s48, s48, 1
    s_bitset1_b32 s48, 15
    s_lshl_b32 s44, s48, 23
    s_lshr_b32 s45, s48, 6
    s_lshl_b32 s45, s45, 23
    s_xor_b32 s52, s44, 0xff800000
    s_xor_b32 s53, s45, 0xff800000
    s_cmp_lg_u32 s3, 0
    s_cbranch_scc1 L_nopub
    s_lshl_b32 s49, s57, 1
    v_mov_b32 v2, s48
    s_mov_b64 exec, 1
    buffer_store_short v2, v22, s[16:19], s49 offen sc0 sc1
    s_mov_b64 exec, s[76:77]
L_nopub:
    s_mov_b32 s46, 116736
    v_lshl_add_u32 v120, v120, 5, s46
    v_lshl_add_u32 v121, v121, 5, s46
    v_lshl_add_u32 v122, v122, 5, s46
    v_lshl_add_u32 v123, v123, 5, s46
    v_lshl_add_u32 v124, v124, 5, s46
    v_lshl_add_u32 v125, v125, 5, s46
    v_lshl_add_u32 v126, v126, 5, s46
    v_lshl_add_u32 v127, v127, 5, s46
    s_waitcnt lgkmcnt(0)
    v_lshl_add_u32 v120, v112, 2, v120
    v_cmpx_gt_u32 vcc, 32, v112
    ds_write_b32 v120, v228
    s_mov_b64 exec, s[76:77]
    v_lshl_add_u32 v121, v113, 2, v121
    v_cmpx_gt_u32 vcc, 32, v113
    ds_write_b32 v121, v229
    s_mov_b64 exec, s[76:77]
    v_lshl_add_u32 v122, v114, 2, v122
    v_cmpx_gt_u32 vcc, 32, v114
    ds_write_b32 v122, v230
    s_mov_b64 exec, s[76:77]
    v_lshl_add_u32 v123, v115, 2, v123
    v_cmpx_gt_u32 vcc, 32, v115
    ds_write_b32 v123, v231
    s_mov_b64 exec, s[76:77]
    v_lshl_add_u32 v124, v116, 2, v124
    v_cmpx_gt_u32 vcc, 32, v116
    ds_write_b32 v124, v232
    s_mov_b64 exec, s[76:77]
    v_lshl_add_u32 v125, v117, 2, v125
    v_cmpx_gt_u32 vcc, 32, v117
    ds_write_b32 v125, v233
    s_mov_b64 exec, s[76:77]
    v_lshl_add_u32 v126, v118, 2, v126
    v_cmpx_gt_u32 vcc, 32, v118
    ds_write_b32 v126, v234
    s_mov_b64 exec, s[76:77]
    v_lshl_add_u32 v127, v119, 2, v127
    v_cmpx_gt_u32 vcc, 32, v119
    ds_write_b32 v127, v235
    s_mov_b64 exec, s[76:77]
    v_max3_u32 v2, v112, v113, v114
    v_max3_u32 v2, v2, v115, v116
    v_max3_u32 v2, v2, v117, v118
    v_max_u32 v2, v2, v119
    v_cmpx_lt_u32 vcc, 31, v2
    ds_write_b32 v22, v1 offset:17508
L_binned:
    s_mov_b64 exec, -1
L_tag:
    s_setprio 0
L_tagd:
    s_lshl_b32 s46, s2, 14
    s_add_u32 s8, s38, s46
    s_addc_u32 s9, s39, 0
    s_and_b32 s9, s9, 0xffff
    s_mov_b32 s10, 16384
    s_mov_b32 s11, 0x20000
    v_add_u32 v241, 0x2000, v23
    s_cmp_lg_u32 s43, 0
    s_cbranch_scc1 L_copied
    s_cmp_eq_u32 s3, 7
    s_cbranch_scc1 L_copied
    v_mov_b32 v1, 1
    s_mov_b64 exec, 1
    s_waitcnt lgkmcnt(0)
    ds_add_u32 v22, v1 offset:17536
    s_mov_b64 exec, -1
    s_cmp_ge_u32 s3, 4
    s_cbranch_scc1 L_copied
    v_add_u32 v240, 116736, v23
    s_mov_b32 s12, s38
    s_and_b32 s13, s39, 0xffff
    s_mov_b32 s14, 4194304
    s_mov_b32 s15, 0x20000
    v_lshrrev_b32 v236, 3, v0
    v_and_b32 v237, 7, v0
    v_lshlrev_b32 v236, 14, v236
    v_lshl_add_u32 v236, v237, 4, v236
L_spin:
    ds_read_b32 v1, v22 offset:17536
    s_waitcnt lgkmcnt(0)
    v_readfirstlane_b32 s50, v1
    s_cmp_lt_u32 s50, 7
    s_cbranch_scc1 L_spin
    ds_read_b32 v1, v22 offset:17508
    ds_read_b128 v[128:131], v240 offset:0
    ds_read_b128 v[132:135], v240 offset:4096
    ds_read_b128 v[136:139], v240 offset:8192
    ds_read_b128 v[140:143], v240 offset:12288
    ds_read_b128 v[144:147], v240 offset:16384
    ds_read_b128 v[148:151], v240 offset:20480
    ds_read_b128 v[152:155], v240 offset:24576
    ds_read_b128 v[156:159], v240 offset:28672
    s_waitcnt lgkmcnt(8)
    v_readfirstlane_b32 s50, v1
    s_cmp_lg_u32 s50, 0
    s_cbranch_scc1 L_ovf
L_copy:
    s_lshl_b32 s50, s57, 7
    s_waitcnt lgkmcnt(7)
    v_xor_b32 v128, s44, v128
    v_xor_b32 v129, s45, v129
    v_xor_b32 v130, s52, v130
    v_xor_b32 v131, s53, v131
    buffer_store_dwordx4 v[128:131], v236, s[12:15], s50 offen sc0 sc1
    s_add_u32 s50, s50, 524288
    s_waitcnt lgkmcnt(6)
    v_xor_b32 v132, s44, v132
    v_xor_b32 v133, s45, v133
    v_xor_b32 v134, s52, v134
    v_xor_b32 v135, s53, v135
    buffer_store_dwordx4 v[132:135], v236, s[12:15], s50 offen sc0 sc1
    s_add_u32 s50, s50, 524288
    s_waitcnt lgkmcnt(5)
    v_xor_b32 v136, s44, v136
    v_xor_b32 v137, s45, v137
    v_xor_b32 v138, s52, v138
    v_xor_b32 v139, s53, v139
    buffer_store_dwordx4 v[136:139], v236, s[12:15], s50 offen sc0 sc1
    s_add_u32 s50, s50, 524288
    s_waitcnt lgkmcnt(4)
    v_xor_b32 v140, s44, v140
    v_xor_b32 v141, s45, v141
    v_xor_b32 v142, s52, v142
    v_xor_b32 v143, s53, v143
    buffer_store_dwordx4 v[140:143], v236, s[12:15], s50 offen sc0 sc1
    s_add_u32 s50, s50, 524288
    s_waitcnt lgkmcnt(3)
    v_xor_b32 v144, s44, v144
    v_xor_b32 v145, s45, v145
    v_xor_b32 v146, s52, v146
    v_xor_b32 v147, s53, v147
    buffer_store_dwordx4 v[144:147], v236, s[12:15], s50 offen sc0 sc1
    s_add_u32 s50, s50, 524288
    s_waitcnt lgkmcnt(2)
    v_xor_b32 v148, s44, v148
    v_xor_b32 v149, s45, v149
    v_xor_b32 v150, s52, v150
    v_xor_b32 v151, s53, v151
    buffer_store_dwordx4 v[148:151], v236, s[12:15], s50 offen sc0 sc1
    s_add_u32 s50, s50, 524288
    s_waitcnt lgkmcnt(1)
    v_xor_b32 v152, s44, v152
    v_xor_b32 v153, s45, v153
    v_xor_b32 v154, s52, v154
    v_xor_b32 v155, s53, v155
    buffer_store_dwordx4 v[152:155], v236, s[12:15], s50 offen sc0 sc1
    s_add_u32 s50, s50, 524288
    s_waitcnt lgkmcnt(0)
    v_xor_b32 v156, s44, v156
    v_xor_b32 v157, s45, v157
    v_xor_b32 v158, s52, v158
    v_xor_b32 v159, s53, v159
    buffer_store_dwordx4 v[156:159], v236, s[12:15], s50 offen sc0 sc1
    v_mov_b32 v1, 1
    s_mov_b64 exec, 1
    ds_add_u32 v22, v1 offset:17536
    s_mov_b64 exec, -1
L_copied:
    v_mov_b32 v236, 0
    v_mov_b32 v237, 0
    v_mov_b32 v238, 0
    v_mov_b32 v239, 0
    ds_write_b128 v23, v[236:239]
    ds_write_b128 v23, v[236:239] offset:8192
    v_and_b32 v1, 7, v28
    v_lshlrev_b32 v1, 1, v1
    v_xor_b32 v2, v1, v29
    v_lshlrev_b32 v2, 4, v2
    v_lshl_add_u32 v3, v28, 8, v2
    v_add_u32 v24, 83968, v3
    v_and_b32 v3, 3, v28
    v_lshrrev_b32 v31, 2, v28
    v_lshl_add_u32 v8, v3, 2, v31
    v_lshl_add_u32 v8, v8, 8, v2
    v_add_u32 v8, s42, v8
    v_xor_b32 v25, 64, v24
    v_xor_b32 v9, 64, v8
    v_xor_b32 v26, 128, v24
    v_xor_b32 v10, 128, v8
    v_xor_b32 v27, 192, v24
    v_xor_b32 v11, 192, v8
    v_and_b32 v2, 1, v29
    v_lshl_or_b32 v2, v2, 2, v31
    v_lshlrev_b32 v2, 5, v2
    v_lshl_or_b32 v2, v3, 3, v2
    v_lshl_add_u32 v12, v31, 2, v29
    v_lshl_add_u32 v12, v12, 8, v2
    v_add_u32 v12, s42, v12
    v_xor_b32 v13, 32, v12
    v_xor_b32 v14, 64, v12
    v_xor_b32 v15, 96, v12
    v_xor_b32 v16, 128, v12
    v_xor_b32 v17, 160, v12
    v_xor_b32 v18, 192, v12
    v_xor_b32 v19, 224, v12
    v_and_b32 v2, 0xe0, v2
    v_lshlrev_b32 v3, 4, v3
    v_xor_b32 v2, v2, v3
    s_and_b32 s50, s3, 3
    s_lshl_b32 s50, s50, 6
    v_xor_b32 v2, s50, v2
    v_lshl_add_u32 v242, v29, 3, v31
    v_lshl_add_u32 v242, v242, 8, v2
    v_add_u32 v242, 18432, v242
    v_lshl_add_u32 v243, v29, 2, v31
    v_lshl_add_u32 v243, v243, 8, v2
    v_add_u32 v243, 51200, v243
    v_and_b32 v2, 1, v29
    v_lshlrev_b32 v2, 3, v2
    v_xor_b32 v2, v2, v28
    v_lshlrev_b32 v4, 4, v2
    v_xor_b32 v5, 32, v4
    v_xor_b32 v6, 64, v4
    v_xor_b32 v7, 96, v4
    s_lshl_b32 s51, s3, 4
    s_add_u32 s51, s51, 1
    v_add_u32 v20, s51, v28
    s_lshr_b32 s51, s3, 2
    s_lshl_b32 s51, s51, 14
    v_add_u32 v244, s51, v24
    v_add_u32 v245, s51, v25
    v_add_u32 v246, s51, v26
    v_add_u32 v247, s51, v27
    v_xor_b32 v1, s50, v244
    v_add_u32 v1, 32768, v1
    s_cmp_lt_u32 s3, 6
    s_cbranch_scc1 L_w4
    s_waitcnt vmcnt(0)
L_w4:
    s_waitcnt lgkmcnt(0)
    s_barrier
    s_cmp_lg_u32 s3, 0
    s_cbranch_scc1 L_nt1
    v_lshlrev_b32 v2, 2, v0
    buffer_load_dword v3, v2, s[16:19], 0 offen sc0 sc1
L_nt1:
    s_mov_b32 s12, s32
    s_and_b32 s13, s33, 0xffff
    s_mov_b32 s14, 32768
    s_mov_b32 s15, 0x20000
    s_lshl_b32 s46, s3, 12
    s_add_u32 m0, s46, 51200
    v_lshlrev_b32 v160, 1, v29
    v_xor_b32 v160, v160, v28
    v_lshlrev_b32 v160, 4, v160
    v_lshl_add_u32 v160, v29, 8, v160
    v_xor_b32 v161, 128, v160
    buffer_load_dwordx4 v160, s[12:15], s46 offen offset:0 lds
    buffer_load_dwordx4 v161, s[12:15], s46 offen offset:1024 lds
    buffer_load_dwordx4 v160, s[12:15], s46 offen offset:2048 lds
    buffer_load_dwordx4 v161, s[12:15], s46 offen offset:3072 lds
    s_mov_b32 s12, s24
    s_and_b32 s13, s25, 0xffff
    s_mov_b32 s14, 1048576
    s_mov_b32 s15, 0x20000
    s_lshl_b32 s47, s56, 3
    s_add_u32 s46, s3, s47
    s_mul_i32 s46, s46, 8192
    v_mul_u32_u24 v162, 128, v30
    v_add_u32 v162, s46, v162
    v_add_u32 v163, 2097152, v162
    buffer_load_dword v251, v162, s[12:15], 0 offen
    buffer_load_dword v251, v163, s[12:15], 0 offen
    ds_read_b64_tr_b16 v[64:65], v242 offset:0
    ds_read_b64_tr_b16 v[66:67], v242 offset:1024
    ds_read_b64_tr_b16 v[68:69], v242 offset:8192
    ds_read_b64_tr_b16 v[70:71], v242 offset:9216
    ds_read_b64_tr_b16 v[72:73], v242 offset:16384
    ds_read_b64_tr_b16 v[74:75], v242 offset:17408
    ds_read_b64_tr_b16 v[76:77], v242 offset:24576
    ds_read_b64_tr_b16 v[78:79], v242 offset:25600
    s_waitcnt lgkmcnt(3)
    ds_read_b64_tr_b16 v[80:81], v242 offset:8
    ds_read_b64_tr_b16 v[82:83], v242 offset:1032
    ds_read_b64_tr_b16 v[84:85], v242 offset:8200
    ds_read_b64_tr_b16 v[86:87], v242 offset:9224
    ds_read_b64_tr_b16 v[88:89], v242 offset:16392
    ds_read_b64_tr_b16 v[90:91], v242 offset:17416
    ds_read_b64_tr_b16 v[92:93], v242 offset:24584
    ds_read_b64_tr_b16 v[94:95], v242 offset:25608
    s_waitcnt lgkmcnt(3)
    ds_read_b128 v[96:99], v244 offset:0
    ds_read_b128 v[100:103], v245 offset:0
    ds_read_b128 v[104:107], v246 offset:0
    ds_read_b128 v[108:111], v247 offset:0
    ds_read_b128 v[112:115], v244 offset:4096
    ds_read_b128 v[116:119], v245 offset:4096
    ds_read_b128 v[120:123], v246 offset:4096
    ds_read_b128 v[124:127], v247 offset:4096
    ds_read_b128 v[128:131], v244 offset:8192
    ds_read_b128 v[132:135], v245 offset:8192
    ds_read_b128 v[136:139], v246 offset:8192
    ds_read_b128 v[140:143], v247 offset:8192
    s_waitcnt lgkmcnt(11)
    v_mfma_f32_16x16x32_bf16 v[32:35], v[64:67], v[96:99], 0
    v_mfma_f32_16x16x32_bf16 v[36:39], v[80:83], v[96:99], 0
    ds_read_b128 v[144:147], v244 offset:12288
    s_waitcnt lgkmcnt(11)
    v_mfma_f32_16x16x32_bf16 v[32:35], v[68:71], v[100:103], v[32:35]
    v_mfma_f32_16x16x32_bf16 v[36:39], v[84:87], v[100:103], v[36:39]
    ds_read_b128 v[148:151], v245 offset:12288
    s_waitcnt lgkmcnt(11)
    v_mfma_f32_16x16x32_bf16 v[32:35], v[72:75], v[104:107], v[32:35]
    v_mfma_f32_16x16x32_bf16 v[36:39], v[88:91], v[104:107], v[36:39]
    ds_read_b128 v[152:155], v246 offset:12288
    s_waitcnt lgkmcnt(11)
    v_mfma_f32_16x16x32_bf16 v[32:35], v[76:79], v[108:111], v[32:35]
    v_mfma_f32_16x16x32_bf16 v[36:39], v[92:95], v[108:111], v[36:39]
    ds_read_b128 v[156:159], v247 offset:12288
    s_waitcnt lgkmcnt(11)
    v_mfma_f32_16x16x32_bf16 v[40:43], v[64:67], v[112:115], 0
    v_mfma_f32_16x16x32_bf16 v[44:47], v[80:83], v[112:115], 0
    s_waitcnt lgkmcnt(10)
    v_mfma_f32_16x16x32_bf16 v[40:43], v[68:71], v[116:119], v[40:43]
    v_mfma_f32_16x16x32_bf16 v[44:47], v[84:87], v[116:119], v[44:47]
    s_waitcnt lgkmcnt(9)
    v_mfma_f32_16x16x32_bf16 v[40:43], v[72:75], v[120:123], v[40:43]
    v_mfma_f32_16x16x32_bf16 v[44:47], v[88:91], v[120:123], v[44:47]
    s_waitcnt lgkmcnt(8)
    v_mfma_f32_16x16x32_bf16 v[40:43], v[76:79], v[124:127], v[40:43]
    v_mfma_f32_16x16x32_bf16 v[44:47], v[92:95], v[124:127], v[44:47]
    s_waitcnt lgkmcnt(7)
    v_mfma_f32_16x16x32_bf16 v[48:51], v[64:67], v[128:131], 0
    v_mfma_f32_16x16x32_bf16 v[52:55], v[80:83], v[128:131], 0
    s_waitcnt lgkmcnt(6)
    v_mfma_f32_16x16x32_bf16 v[48:51], v[68:71], v[132:135], v[48:51]
    v_mfma_f32_16x16x32_bf16 v[52:55], v[84:87], v[132:135], v[52:55]
    s_waitcnt lgkmcnt(5)
    v_mfma_f32_16x16x32_bf16 v[48:51], v[72:75], v[136:139], v[48:51]
    v_mfma_f32_16x16x32_bf16 v[52:55], v[88:91], v[136:139], v[52:55]
    s_waitcnt lgkmcnt(4)
    v_mfma_f32_16x16x32_bf16 v[48:51], v[76:79], v[140:143], v[48:51]
    v_mfma_f32_16x16x32_bf16 v[52:55], v[92:95], v[140:143], v[52:55]
    s_waitcnt lgkmcnt(3)
    v_mfma_f32_16x16x32_bf16 v[56:59], v[64:67], v[144:147], 0
    v_mfma_f32_16x16x32_bf16 v[60:63], v[80:83], v[144:147], 0
    s_waitcnt lgkmcnt(2)
    v_mfma_f32_16x16x32_bf16 v[56:59], v[68:71], v[148:151], v[56:59]
    v_mfma_f32_16x16x32_bf16 v[60:63], v[84:87], v[148:151], v[60:63]
    s_waitcnt lgkmcnt(1)
    v_mfma_f32_16x16x32_bf16 v[56:59], v[72:75], v[152:155], v[56:59]
    v_mfma_f32_16x16x32_bf16 v[60:63], v[88:91], v[152:155], v[60:63]
    s_waitcnt lgkmcnt(0)
    v_mfma_f32_16x16x32_bf16 v[56:59], v[76:79], v[156:159], v[56:59]
    v_mfma_f32_16x16x32_bf16 v[60:63], v[92:95], v[156:159], v[60:63]
    buffer_load_dwordx4 v[228:231], v23, s[8:11], 0 offen sc0 sc1
    buffer_load_dwordx4 v[232:235], v241, s[8:11], 0 offen sc0 sc1
    s_nop 4
    s_mov_b32 s51, 0xbe0293ee
    v_mul_f32 v32, s51, v32
    v_mul_f32 v33, s51, v33
    v_mul_f32 v34, s51, v34
    v_mul_f32 v35, s51, v35
    v_mul_f32 v36, s51, v36
    v_mul_f32 v37, s51, v37
    v_mul_f32 v38, s51, v38
    v_mul_f32 v39, s51, v39
    v_cvt_pk_bf16_f32 v96, v32, v33
    v_cvt_pk_bf16_f32 v97, v34, v35
    v_cvt_pk_bf16_f32 v98, v36, v37
    v_cvt_pk_bf16_f32 v99, v38, v39
    ds_write_b128 v1, v[96:99] offset:0
    v_mul_f32 v40, s51, v40
    v_mul_f32 v41, s51, v41
    v_mul_f32 v42, s51, v42
    v_mul_f32 v43, s51, v43
    v_mul_f32 v44, s51, v44
    v_mul_f32 v45, s51, v45
    v_mul_f32 v46, s51, v46
    v_mul_f32 v47, s51, v47
    v_cvt_pk_bf16_f32 v100, v40, v41
    v_cvt_pk_bf16_f32 v101, v42, v43
    v_cvt_pk_bf16_f32 v102, v44, v45
    v_cvt_pk_bf16_f32 v103, v46, v47
    ds_write_b128 v1, v[100:103] offset:4096
    v_mul_f32 v48, s51, v48
    v_mul_f32 v49, s51, v49
    v_mul_f32 v50, s51, v50
    v_mul_f32 v51, s51, v51
    v_mul_f32 v52, s51, v52
    v_mul_f32 v53, s51, v53
    v_mul_f32 v54, s51, v54
    v_mul_f32 v55, s51, v55
    v_cvt_pk_bf16_f32 v104, v48, v49
    v_cvt_pk_bf16_f32 v105, v50, v51
    v_cvt_pk_bf16_f32 v106, v52, v53
    v_cvt_pk_bf16_f32 v107, v54, v55
    ds_write_b128 v1, v[104:107] offset:8192
    v_mul_f32 v56, s51, v56
    v_mul_f32 v57, s51, v57
    v_mul_f32 v58, s51, v58
    v_mul_f32 v59, s51, v59
    v_mul_f32 v60, s51, v60
    v_mul_f32 v61, s51, v61
    v_mul_f32 v62, s51, v62
    v_mul_f32 v63, s51, v63
    v_cvt_pk_bf16_f32 v108, v56, v57
    v_cvt_pk_bf16_f32 v109, v58, v59
    v_cvt_pk_bf16_f32 v110, v60, v61
    v_cvt_pk_bf16_f32 v111, v62, v63
    ds_write_b128 v1, v[108:111] offset:12288
    v_mov_b32 v32, 0
    v_mov_b32 v33, 0
    v_mov_b32 v34, 0
    v_mov_b32 v35, 0
    v_mov_b32 v36, 0
    v_mov_b32 v37, 0
    v_mov_b32 v38, 0
    v_mov_b32 v39, 0
    v_mov_b32 v40, 0
    v_mov_b32 v41, 0
    v_mov_b32 v42, 0
    v_mov_b32 v43, 0
    v_mov_b32 v44, 0
    v_mov_b32 v45, 0
    v_mov_b32 v46, 0
    v_mov_b32 v47, 0
    v_mov_b32 v48, 0
    v_mov_b32 v49, 0
    v_mov_b32 v50, 0
    v_mov_b32 v51, 0
    v_mov_b32 v52, 0
    v_mov_b32 v53, 0
    v_mov_b32 v54, 0
    v_mov_b32 v55, 0
    v_mov_b32 v56, 0
    v_mov_b32 v57, 0
    v_mov_b32 v58, 0
    v_mov_b32 v59, 0
    v_mov_b32 v60, 0
    v_mov_b32 v61, 0
    v_mov_b32 v62, 0
    v_mov_b32 v63, 0
    s_lshl_b32 s51, s3, 12
    s_add_u32 s51, s51, 32768
    v_add_u32 v236, s51, v24
    v_add_u32 v237, s51, v25
    v_add_u32 v238, s51, v26
    v_add_u32 v239, s51, v27
    s_waitcnt vmcnt(4)
    s_cmp_lg_u32 s3, 0
    s_cbranch_scc1 L_nt2
    s_mov_b32 s50, 4000
    s_mov_b32 s51, 0x80008000
L_tp:
    v_and_b32 v1, s51, v3
    v_cmp_ne_u32 vcc, s51, v1
    s_cbranch_vccz L_tp2
    buffer_load_dword v3, v2, s[16:19], 0 offen sc0 sc1
    s_waitcnt vmcnt(0)
    s_sub_u32 s50, s50, 1
    s_cbranch_scc0 L_tp
L_tp2:
    ds_write_b32 v2, v3 offset:17664
L_nt2:
    s_mov_b32 s16, s34
    s_and_b32 s17, s35, 0xffff
    s_mov_b32 s18, 6400000
    s_mov_b32 s19, 0x20000
    v_lshrrev_b32 v1, 2, v0
    v_and_b32 v1, 0x7e, v1
    s_waitcnt lgkmcnt(0)
    s_barrier
    ds_read_u16 v2, v1 offset:17664
    ds_read_u16 v3, v1 offset:17792
    ds_read_b128 v[64:67], v236
    ds_read_b128 v[68:71], v237
    ds_read_b128 v[72:75], v238
    ds_read_b128 v[76:79], v239
    ds_read_b64_tr_b16 v[196:197], v243 offset:0
    ds_read_b64_tr_b16 v[198:199], v243 offset:4096
    ds_read_b64_tr_b16 v[200:201], v243 offset:8192
    ds_read_b64_tr_b16 v[202:203], v243 offset:12288
    ds_read_b64_tr_b16 v[204:205], v243 offset:16384
    ds_read_b64_tr_b16 v[206:207], v243 offset:20480
    ds_read_b64_tr_b16 v[208:209], v243 offset:24576
    ds_read_b64_tr_b16 v[210:211], v243 offset:28672
    s_waitcnt lgkmcnt(7)
    ds_read_b64_tr_b16 v[212:213], v243 offset:8
    ds_read_b64_tr_b16 v[214:215], v243 offset:4104
    ds_read_b64_tr_b16 v[216:217], v243 offset:8200
    ds_read_b64_tr_b16 v[218:219], v243 offset:12296
    ds_read_b64_tr_b16 v[220:221], v243 offset:16392
    ds_read_b64_tr_b16 v[222:223], v243 offset:20488
    ds_read_b64_tr_b16 v[224:225], v243 offset:24584
    ds_read_b64_tr_b16 v[226:227], v243 offset:28680
    s_mov_b32 s50, 4000
    s_mov_b32 s51, 0xff800000
    v_lshlrev_b32 v144, 23, v2
    v_lshrrev_b32 v145, 6, v2
    v_lshlrev_b32 v145, 23, v145
    v_xor_b32 v146, s51, v144
    v_xor_b32 v147, s51, v145
    v_lshlrev_b32 v148, 23, v3
    v_lshrrev_b32 v149, 6, v3
    v_lshlrev_b32 v149, 23, v149
    v_xor_b32 v150, s51, v148
    v_xor_b32 v151, s51, v149
    v_and_b32 v2, v2, v3
    v_cmp_gt_u32 vcc, 0x8000, v2
    s_cbranch_vccnz L_fail
    s_mov_b32 s51, 0x800000
L_poll:
    s_waitcnt vmcnt(0)
    v_xor_b32 v112, v144, v228
    v_xor_b32 v113, v145, v229
    v_xor_b32 v114, v146, v230
    v_xor_b32 v115, v147, v231
    v_xor_b32 v116, v148, v232
    v_xor_b32 v117, v149, v233
    v_xor_b32 v118, v150, v234
    v_xor_b32 v119, v151, v235
    v_or3_b32 v1, v112, v113, v114
    v_or3_b32 v2, v116, v117, v118
    v_or3_b32 v1, v1, v115, v119
    v_or_b32 v1, v1, v2
    v_cmpx_le_u32 vcc, s51, v1
    s_cbranch_execz L_got
    buffer_load_dwordx4 v[228:231], v23, s[8:11], 0 offen sc0 sc1
    buffer_load_dwordx4 v[232:235], v241, s[8:11], 0 offen sc0 sc1
    s_sub_u32 s50, s50, 1
    s_cbranch_scc0 L_poll
    s_mov_b64 exec, -1
L_fail:
    s_waitcnt vmcnt(0)
    s_lshl_b32 s50, s3, 3
    s_lshl_b32 s50, 0xff, s50
    s_and_b32 s51, s3, 4
    v_mov_b32 v1, s50
    v_mov_b32 v2, s51
    ds_or_b32 v2, v1 offset:17520
    ds_or_b32 v2, v1 offset:17528
    v_mov_b32 v112, 0
    v_mov_b32 v113, 0
    v_mov_b32 v114, 0
    v_mov_b32 v115, 0
    v_mov_b32 v116, 0
    v_mov_b32 v117, 0
    v_mov_b32 v118, 0
    v_mov_b32 v119, 0
L_got:
    s_mov_b64 exec, -1
    s_lshl_b32 s47, s56, 3
    s_add_u32 s46, s3, s47
    s_mul_i32 s46, s46, 4096
    s_add_u32 s46, s46, 1048576
    v_lshlrev_b32 v162, 7, v30
    s_mov_b64 exec, 0xffffffff
    buffer_load_dword v251, v162, s[4:7], s46 offen
    s_mov_b64 exec, -1
    v_cmp_eq_u32 vcc, 0x70, v112
    v_mov_b32 v1, 0x70
    v_cmp_eq_u32 s[50:51], v1, v116
    v_mov_b32 v228, v112
    v_mov_b32 v229, v113
    v_mov_b32 v230, v114
    v_mov_b32 v231, v115
    v_mov_b32 v232, v116
    v_mov_b32 v233, v117
    v_mov_b32 v234, v118
    v_mov_b32 v235, v119
    s_or_b64 s[54:55], vcc, s[50:51]
    s_cbranch_scc1 L_mark
L_place:
    v_mov_b32 v1, 1
    v_lshrrev_b32 v120, 2, v228
    v_and_b32 v120, 0x3c, v120
    v_mov_b32 v112, -1
    v_cmpx_ne_u32 vcc, 0, v228
    ds_add_rtn_u32 v112, v120, v1 offset:17440
    s_mov_b64 exec, -1
    v_lshrrev_b32 v121, 2, v229
    v_and_b32 v121, 0x3c, v121
    v_mov_b32 v113, -1
    v_cmpx_ne_u32 vcc, 0, v229
    ds_add_rtn_u32 v113, v121, v1 offset:17440
    s_mov_b64 exec, -1
    v_lshrrev_b32 v122, 2, v230
    v_and_b32 v122, 0x3c, v122
    v_mov_b32 v114, -1
    v_cmpx_ne_u32 vcc, 0, v230
    ds_add_rtn_u32 v114, v122, v1 offset:17440
    s_mov_b64 exec, -1
    v_lshrrev_b32 v123, 2, v231
    v_and_b32 v123, 0x3c, v123
    v_mov_b32 v115, -1
    v_cmpx_ne_u32 vcc, 0, v231
    ds_add_rtn_u32 v115, v123, v1 offset:17440
    s_mov_b64 exec, -1
    v_lshrrev_b32 v124, 2, v232
    v_and_b32 v124, 0x3c, v124
    v_mov_b32 v116, -1
    v_cmpx_ne_u32 vcc, 0, v232
    ds_add_rtn_u32 v116, v124, v1 offset:17440
    s_mov_b64 exec, -1
    v_lshrrev_b32 v125, 2, v233
    v_and_b32 v125, 0x3c, v125
    v_mov_b32 v117, -1
    v_cmpx_ne_u32 vcc, 0, v233
    ds_add_rtn_u32 v117, v125, v1 offset:17440
    s_mov_b64 exec, -1
    v_lshrrev_b32 v126, 2, v234
    v_and_b32 v126, 0x3c, v126
    v_mov_b32 v118, -1
    v_cmpx_ne_u32 vcc, 0, v234
    ds_add_rtn_u32 v118, v126, v1 offset:17440
    s_mov_b64 exec, -1
    v_lshrrev_b32 v127, 2, v235
    v_and_b32 v127, 0x3c, v127
    v_mov_b32 v119, -1
    v_cmpx_ne_u32 vcc, 0, v235
    ds_add_rtn_u32 v119, v127, v1 offset:17440
    s_mov_b64 exec, -1
    v_and_b32 v144, 0x1c, v120
    v_lshlrev_b32 v144, 9, v144
    v_and_b32 v145, 0x1c, v121
    v_lshlrev_b32 v145, 9, v145
    v_and_b32 v146, 0x1c, v122
    v_lshlrev_b32 v146, 9, v146
    v_and_b32 v147, 0x1c, v123
    v_lshlrev_b32 v147, 9, v147
    v_and_b32 v148, 0x1c, v124
    v_lshlrev_b32 v148, 9, v148
    v_and_b32 v149, 0x1c, v125
    v_lshlrev_b32 v149, 9, v149
    v_and_b32 v150, 0x1c, v126
    v_lshlrev_b32 v150, 9, v150
    v_and_b32 v151, 0x1c, v127
    v_lshlrev_b32 v151, 9, v151
    s_lshl_b32 s50, s3, 2
    v_mov_b32 v3, s50
    s_mov_b32 s51, 384
    s_waitcnt lgkmcnt(0)
    s_barrier
    ds_read_b32 v120, v120 offset:17408
    ds_read_b32 v121, v121 offset:17408
    ds_read_b32 v122, v122 offset:17408
    ds_read_b32 v123, v123 offset:17408
    ds_read_b32 v124, v124 offset:17408
    ds_read_b32 v125, v125 offset:17408
    ds_read_b32 v126, v126 offset:17408
    ds_read_b32 v127, v127 offset:17408
    ds_read_b32 v236, v3 offset:17440
    ds_read_b32 v237, v3 offset:17472
    s_waitcnt lgkmcnt(0)
    v_add_u32 v112, v112, v120
    v_lshl_add_u32 v144, v112, 2, v144
    v_and_b32 v120, 0xffffff7f, v228
    v_cmpx_gt_u32 vcc, s51, v112
    ds_write_b32 v144, v120
    v_mov_b32 v228, 0
    s_mov_b64 exec, -1
    v_add_u32 v113, v113, v121
    v_lshl_add_u32 v145, v113, 2, v145
    v_and_b32 v121, 0xffffff7f, v229
    v_cmpx_gt_u32 vcc, s51, v113
    ds_write_b32 v145, v121
    v_mov_b32 v229, 0
    s_mov_b64 exec, -1
    v_add_u32 v114, v114, v122
    v_lshl_add_u32 v146, v114, 2, v146
    v_and_b32 v122, 0xffffff7f, v230
    v_cmpx_gt_u32 vcc, s51, v114
    ds_write_b32 v146, v122
    v_mov_b32 v230, 0
    s_mov_b64 exec, -1
    v_add_u32 v115, v115, v123
    v_lshl_add_u32 v147, v115, 2, v147
    v_and_b32 v123, 0xffffff7f, v231
    v_cmpx_gt_u32 vcc, s51, v115
    ds_write_b32 v147, v123
    v_mov_b32 v231, 0
    s_mov_b64 exec, -1
    v_add_u32 v116, v116, v124
    v_lshl_add_u32 v148, v116, 2, v148
    v_and_b32 v124, 0xffffff7f, v232
    v_cmpx_gt_u32 vcc, s51, v116
    ds_write_b32 v148, v124
    v_mov_b32 v232, 0
    s_mov_b64 exec, -1
    v_add_u32 v117, v117, v125
    v_lshl_add_u32 v149, v117, 2, v149
    v_and_b32 v125, 0xffffff7f, v233
    v_cmpx_gt_u32 vcc, s51, v117
    ds_write_b32 v149, v125
    v_mov_b32 v233, 0
    s_mov_b64 exec, -1
    v_add_u32 v118, v118, v126
    v_lshl_add_u32 v150, v118, 2, v150
    v_and_b32 v126, 0xffffff7f, v234
    v_cmpx_gt_u32 vcc, s51, v118
    ds_write_b32 v150, v126
    v_mov_b32 v234, 0
    s_mov_b64 exec, -1
    v_add_u32 v119, v119, v127
    v_lshl_add_u32 v151, v119, 2, v151
    v_and_b32 v127, 0xffffff7f, v235
    v_cmpx_gt_u32 vcc, s51, v119
    ds_write_b32 v151, v127
    v_mov_b32 v235, 0
    s_mov_b64 exec, -1
    v_or3_b32 v1, v228, v229, v230
    v_or3_b32 v1, v1, v231, v232
    v_or3_b32 v1, v1, v233, v234
    v_or_b32 v1, v1, v235
    v_cmpx_ne_u32 vcc, 0, v1
    ds_write_b32 v22, v1 offset:17504
    s_mov_b64 exec, -1
    v_add_u32 v236, v236, v237
    s_lshl_b32 s50, s3, 11
    v_lshl_add_u32 v21, v29, 5, s50
    v_readfirstlane_b32 s53, v236
    s_waitcnt lgkmcnt(0)
    s_barrier
    ds_read_b128 v[168:171], v21 offset:0
    ds_read_b128 v[172:175], v21 offset:16
    ds_read_b128 v[176:179], v21 offset:128
    ds_read_b128 v[180:183], v21 offset:144
    ds_read_b32 v1, v22 offset:17504
    ds_read_b128 v[236:239], v22 offset:17520
    s_min_u32 s53, s53, s51
    s_add_u32 s53, s53, 31
    s_lshr_b32 s53, s53, 5
    s_cmp_eq_u32 s53, 0
    s_cbranch_scc1 L_noi
    s_waitcnt lgkmcnt(4)
    s_add_u32 m0, s42, 0
    v_and_or_b32 v188, v168, s40, v4
    buffer_load_dwordx4 v188, s[4:7], 0 offen lds
    s_add_u32 m0, m0, 1024
    v_and_or_b32 v189, v169, s40, v5
    buffer_load_dwordx4 v189, s[4:7], 0 offen lds
    s_add_u32 m0, m0, 1024
    v_and_or_b32 v190, v170, s40, v6
    buffer_load_dwordx4 v190, s[4:7], 0 offen lds
    s_add_u32 m0, m0, 1024
    v_and_or_b32 v191, v171, s40, v7
    buffer_load_dwordx4 v191, s[4:7], 0 offen lds
    s_add_u32 m0, m0, 1024
    v_and_or_b32 v192, v172, s40, v4
    buffer_load_dwordx4 v192, s[4:7], 0 offen lds
    s_add_u32 m0, m0, 1024
    v_and_or_b32 v193, v173, s40, v5
    buffer_load_dwordx4 v193, s[4:7], 0 offen lds
    s_add_u32 m0, m0, 1024
    v_and_or_b32 v194, v174, s40, v6
    buffer_load_dwordx4 v194, s[4:7], 0 offen lds
    s_add_u32 m0, m0, 1024
    v_and_or_b32 v195, v175, s40, v7
    buffer_load_dwordx4 v195, s[4:7], 0 offen lds
    s_cmp_eq_u32 s53, 1
    s_cbranch_scc1 L_noi
    s_waitcnt lgkmcnt(2)
    s_add_u32 m0, s42, 8192
    v_and_or_b32 v188, v176, s40, v4
    buffer_load_dwordx4 v188, s[4:7], 0 offen lds
    s_add_u32 m0, m0, 1024
    v_and_or_b32 v189, v177, s40, v5
    buffer_load_dwordx4 v189, s[4:7], 0 offen lds
    s_add_u32 m0, m0, 1024
    v_and_or_b32 v190, v178, s40, v6
    buffer_load_dwordx4 v190, s[4:7], 0 offen lds
    s_add_u32 m0, m0, 1024
    v_and_or_b32 v191, v179, s40, v7
    buffer_load_dwordx4 v191, s[4:7], 0 offen lds
    s_add_u32 m0, m0, 1024
    v_and_or_b32 v192, v180, s40, v4
    buffer_load_dwordx4 v192, s[4:7], 0 offen lds
    s_add_u32 m0, m0, 1024
    v_and_or_b32 v193, v181, s40, v5
    buffer_load_dwordx4 v193, s[4:7], 0 offen lds
    s_add_u32 m0, m0, 1024
    v_and_or_b32 v194, v182, s40, v6
    buffer_load_dwordx4 v194, s[4:7], 0 offen lds
    s_add_u32 m0, m0, 1024
    v_and_or_b32 v195, v183, s40, v7
    buffer_load_dwordx4 v195, s[4:7], 0 offen lds
L_noi:
    s_waitcnt lgkmcnt(0)
    v_readfirstlane_b32 s52, v1
    v_readfirstlane_b32 s76, v236
    v_readfirstlane_b32 s77, v237
    v_readfirstlane_b32 s78, v238
    v_readfirstlane_b32 s79, v239
    s_cmp_eq_u32 s53, 0
    s_cbranch_scc1 L_done
    s_cmp_lt_u32 s3, 4
    s_cbranch_scc1 L_loop
    s_setprio 1
L_loop:
    s_cmp_eq_u32 s53, 1
    s_cbranch_scc1 W0_0
    s_waitcnt vmcnt(8)
    s_branch W1_0
W0_0:
    s_waitcnt vmcnt(0)
W1_0:
    ds_read_b128 v[96:99], v8 offset:0
    ds_read_b128 v[100:103], v9 offset:0
    ds_read_b128 v[104:107], v10 offset:0
    ds_read_b128 v[108:111], v11 offset:0
    ds_read_b128 v[112:115], v8 offset:4096
    ds_read_b128 v[116:119], v9 offset:4096
    ds_read_b128 v[120:123], v10 offset:4096
    ds_read_b128 v[124:127], v11 offset:4096
    v_cmp_eq_u32_sdwa s[60:61], v168, v20 src0_sel:BYTE_0 src1_sel:DWORD
    v_cmp_eq_u32_sdwa s[62:63], v169, v20 src0_sel:BYTE_0 src1_sel:DWORD
    v_cmp_eq_u32_sdwa s[64:65], v170, v20 src0_sel:BYTE_0 src1_sel:DWORD
    v_cmp_eq_u32_sdwa s[66:67], v171, v20 src0_sel:BYTE_0 src1_sel:DWORD
    v_cmp_eq_u32_sdwa s[68:69], v172, v20 src0_sel:BYTE_0 src1_sel:DWORD
    v_cmp_eq_u32_sdwa s[70:71], v173, v20 src0_sel:BYTE_0 src1_sel:DWORD
    v_cmp_eq_u32_sdwa s[72:73], v174, v20 src0_sel:BYTE_0 src1_sel:DWORD
    v_cmp_eq_u32_sdwa s[74:75], v175, v20 src0_sel:BYTE_0 src1_sel:DWORD
    ds_read_b128 v[168:171], v21 offset:256
    ds_read_b128 v[172:175], v21 offset:272
    ds_read_b64_tr_b16 v[128:129], v12 offset:0
    ds_read_b64_tr_b16 v[130:131], v12 offset:4096
    ds_read_b64_tr_b16 v[132:133], v13 offset:0
    ds_read_b64_tr_b16 v[134:135], v13 offset:4096
    ds_read_b64_tr_b16 v[136:137], v14 offset:0
    s_waitcnt lgkmcnt(11)
    v_mfma_f32_16x16x32_bf16 v[160:163], v[96:99], v[64:67], 0
    v_mfma_f32_16x16x32_bf16 v[160:163], v[100:103], v[68:71], v[160:163]
    v_mfma_f32_16x16x32_bf16 v[160:163], v[104:107], v[72:75], v[160:163]
    v_mfma_f32_16x16x32_bf16 v[160:163], v[108:111], v[76:79], v[160:163]
    ds_read_b64_tr_b16 v[138:139], v14 offset:4096
    ds_read_b64_tr_b16 v[140:141], v15 offset:0
    ds_read_b64_tr_b16 v[142:143], v15 offset:4096
    ds_read_b64_tr_b16 v[144:145], v16 offset:0
    s_waitcnt lgkmcnt(11)
    v_mfma_f32_16x16x32_bf16 v[164:167], v[112:115], v[64:67], 0
    v_mfma_f32_16x16x32_bf16 v[164:167], v[116:119], v[68:71], v[164:167]
    v_mfma_f32_16x16x32_bf16 v[164:167], v[120:123], v[72:75], v[164:167]
    v_mfma_f32_16x16x32_bf16 v[164:167], v[124:127], v[76:79], v[164:167]
    ds_read_b64_tr_b16 v[146:147], v16 offset:4096
    ds_read_b64_tr_b16 v[148:149], v17 offset:0
    ds_read_b64_tr_b16 v[150:151], v17 offset:4096
    ds_read_b64_tr_b16 v[152:153], v18 offset:0
    s_waitcnt lgkmcnt(11)
    ds_read_b64_tr_b16 v[154:155], v18 offset:4096
    ds_read_b64_tr_b16 v[156:157], v19 offset:0
    ds_read_b64_tr_b16 v[158:159], v19 offset:4096
    v_exp_f32 v160, v160
    v_exp_f32 v161, v161
    v_exp_f32 v162, v162
    v_exp_f32 v163, v163
    s_cmp_lt_u32 s53, 3
    s_cbranch_scc1 NI_0
    s_waitcnt lgkmcnt(0)
    s_add_u32 m0, s42, 0
    v_and_or_b32 v188, v168, s40, v4
    buffer_load_dwordx4 v188, s[4:7], 0 offen lds
    v_exp_f32 v164, v164
    v_exp_f32 v165, v165
    v_exp_f32 v166, v166
    s_add_u32 m0, m0, 1024
    v_and_or_b32 v189, v169, s40, v5
    buffer_load_dwordx4 v189, s[4:7], 0 offen lds
    v_exp_f32 v167, v167
    v_add_f32 v160, 1.0, v160
    v_add_f32 v161, 1.0, v161
    s_add_u32 m0, m0, 1024
    v_and_or_b32 v190, v170, s40, v6
    buffer_load_dwordx4 v190, s[4:7], 0 offen lds
    v_add_f32 v162, 1.0, v162
    v_add_f32 v163, 1.0, v163
    v_add_f32 v164, 1.0, v164
    s_add_u32 m0, m0, 1024
    v_and_or_b32 v191, v171, s40, v7
    buffer_load_dwordx4 v191, s[4:7], 0 offen lds
    v_add_f32 v165, 1.0, v165
    v_add_f32 v166, 1.0, v166
    v_add_f32 v167, 1.0, v167
    s_add_u32 m0, m0, 1024
    v_and_or_b32 v192, v172, s40, v4
    buffer_load_dwordx4 v192, s[4:7], 0 offen lds
    v_rcp_f32 v160, v160
    v_rcp_f32 v161, v161
    v_rcp_f32 v162, v162
    s_add_u32 m0, m0, 1024
    v_and_or_b32 v193, v173, s40, v5
    buffer_load_dwordx4 v193, s[4:7], 0 offen lds
    v_rcp_f32 v163, v163
    v_rcp_f32 v164, v164
    v_rcp_f32 v165, v165
    s_add_u32 m0, m0, 1024
    v_and_or_b32 v194, v174, s40, v6
    buffer_load_dwordx4 v194, s[4:7], 0 offen lds
    v_rcp_f32 v166, v166
    v_rcp_f32 v167, v167
    v_cndmask_b32 v160, 0, v160, s[60:61]
    s_add_u32 m0, m0, 1024
    v_and_or_b32 v195, v175, s40, v7
    buffer_load_dwordx4 v195, s[4:7], 0 offen lds
    v_cndmask_b32 v161, 0, v161, s[62:63]
    v_cndmask_b32 v162, 0, v162, s[64:65]
    v_cndmask_b32 v163, 0, v163, s[66:67]
    v_cndmask_b32 v164, 0, v164, s[68:69]
    v_cndmask_b32 v165, 0, v165, s[70:71]
    v_cndmask_b32 v166, 0, v166, s[72:73]
    v_cndmask_b32 v167, 0, v167, s[74:75]
    v_cvt_pk_bf16_f32 v184, v160, v161
    v_cvt_pk_bf16_f32 v185, v162, v163
    v_cvt_pk_bf16_f32 v186, v164, v165
    v_cvt_pk_bf16_f32 v187, v166, v167
    s_branch DI_0
NI_0:
    s_nop 1
    v_exp_f32 v164, v164
    v_exp_f32 v165, v165
    v_exp_f32 v166, v166
    v_exp_f32 v167, v167
    v_add_f32 v160, 1.0, v160
    v_add_f32 v161, 1.0, v161
    v_add_f32 v162, 1.0, v162
    v_add_f32 v163, 1.0, v163
    v_add_f32 v164, 1.0, v164
    v_add_f32 v165, 1.0, v165
    v_add_f32 v166, 1.0, v166
    v_add_f32 v167, 1.0, v167
    v_rcp_f32 v160, v160
    v_rcp_f32 v161, v161
    v_rcp_f32 v162, v162
    v_rcp_f32 v163, v163
    v_rcp_f32 v164, v164
    v_rcp_f32 v165, v165
    v_rcp_f32 v166, v166
    v_rcp_f32 v167, v167
    v_cndmask_b32 v160, 0, v160, s[60:61]
    v_cndmask_b32 v161, 0, v161, s[62:63]
    v_cndmask_b32 v162, 0, v162, s[64:65]
    v_cndmask_b32 v163, 0, v163, s[66:67]
    v_cndmask_b32 v164, 0, v164, s[68:69]
    v_cndmask_b32 v165, 0, v165, s[70:71]
    v_cndmask_b32 v166, 0, v166, s[72:73]
    v_cndmask_b32 v167, 0, v167, s[74:75]
    v_cvt_pk_bf16_f32 v184, v160, v161
    v_cvt_pk_bf16_f32 v185, v162, v163
    v_cvt_pk_bf16_f32 v186, v164, v165
    v_cvt_pk_bf16_f32 v187, v166, v167
    s_waitcnt lgkmcnt(0)
DI_0:
    s_sub_u32 s53, s53, 1
    s_cmp_eq_u32 s53, 0
    v_mfma_f32_16x16x32_bf16 v[32:35], v[128:131], v[184:187], v[32:35]
    v_mfma_f32_16x16x32_bf16 v[36:39], v[132:135], v[184:187], v[36:39]
    v_mfma_f32_16x16x32_bf16 v[40:43], v[136:139], v[184:187], v[40:43]
    v_mfma_f32_16x16x32_bf16 v[44:47], v[140:143], v[184:187], v[44:47]
    v_mfma_f32_16x16x32_bf16 v[48:51], v[144:147], v[184:187], v[48:51]
    v_mfma_f32_16x16x32_bf16 v[52:55], v[148:151], v[184:187], v[52:55]
    v_mfma_f32_16x16x32_bf16 v[56:59], v[152:155], v[184:187], v[56:59]
    v_mfma_f32_16x16x32_bf16 v[60:63], v[156:159], v[184:187], v[60:63]
    s_cbranch_scc1 L_done
    s_cmp_eq_u32 s53, 1
    s_cbranch_scc1 W0_1
    s_waitcnt vmcnt(8)
    s_branch W1_1
W0_1:
    s_waitcnt vmcnt(0)
W1_1:
    ds_read_b128 v[96:99], v8 offset:8192
    ds_read_b128 v[100:103], v9 offset:8192
    ds_read_b128 v[104:107], v10 offset:8192
    ds_read_b128 v[108:111], v11 offset:8192
    ds_read_b128 v[112:115], v8 offset:12288
    ds_read_b128 v[116:119], v9 offset:12288
    ds_read_b128 v[120:123], v10 offset:12288
    ds_read_b128 v[124:127], v11 offset:12288
    v_cmp_eq_u32_sdwa s[60:61], v176, v20 src0_sel:BYTE_0 src1_sel:DWORD
    v_cmp_eq_u32_sdwa s[62:63], v177, v20 src0_sel:BYTE_0 src1_sel:DWORD
    v_cmp_eq_u32_sdwa s[64:65], v178, v20 src0_sel:BYTE_0 src1_sel:DWORD
    v_cmp_eq_u32_sdwa s[66:67], v179, v20 src0_sel:BYTE_0 src1_sel:DWORD
    v_cmp_eq_u32_sdwa s[68:69], v180, v20 src0_sel:BYTE_0 src1_sel:DWORD
    v_cmp_eq_u32_sdwa s[70:71], v181, v20 src0_sel:BYTE_0 src1_sel:DWORD
    v_cmp_eq_u32_sdwa s[72:73], v182, v20 src0_sel:BYTE_0 src1_sel:DWORD
    v_cmp_eq_u32_sdwa s[74:75], v183, v20 src0_sel:BYTE_0 src1_sel:DWORD
    ds_read_b128 v[176:179], v21 offset:384
    ds_read_b128 v[180:183], v21 offset:400
    ds_read_b64_tr_b16 v[128:129], v12 offset:8192
    ds_read_b64_tr_b16 v[130:131], v12 offset:12288
    ds_read_b64_tr_b16 v[132:133], v13 offset:8192
    ds_read_b64_tr_b16 v[134:135], v13 offset:12288
    ds_read_b64_tr_b16 v[136:137], v14 offset:8192
    s_waitcnt lgkmcnt(11)
    v_mfma_f32_16x16x32_bf16 v[160:163], v[96:99], v[64:67], 0
    v_mfma_f32_16x16x32_bf16 v[160:163], v[100:103], v[68:71], v[160:163]
    v_mfma_f32_16x16x32_bf16 v[160:163], v[104:107], v[72:75], v[160:163]
    v_mfma_f32_16x16x32_bf16 v[160:163], v[108:111], v[76:79], v[160:163]
    ds_read_b64_tr_b16 v[138:139], v14 offset:12288
    ds_read_b64_tr_b16 v[140:141], v15 offset:8192
    ds_read_b64_tr_b16 v[142:143], v15 offset:12288
    ds_read_b64_tr_b16 v[144:145], v16 offset:8192
    s_waitcnt lgkmcnt(11)
    v_mfma_f32_16x16x32_bf16 v[164:167], v[112:115], v[64:67], 0
    v_mfma_f32_16x16x32_bf16 v[164:167], v[116:119], v[68:71], v[164:167]
    v_mfma_f32_16x16x32_bf16 v[164:167], v[120:123], v[72:75], v[164:167]
    v_mfma_f32_16x16x32_bf16 v[164:167], v[124:127], v[76:79], v[164:167]
    ds_read_b64_tr_b16 v[146:147], v16 offset:12288
    ds_read_b64_tr_b16 v[148:149], v17 offset:8192
    ds_read_b64_tr_b16 v[150:151], v17 offset:12288
    ds_read_b64_tr_b16 v[152:153], v18 offset:8192
    s_waitcnt lgkmcnt(11)
    ds_read_b64_tr_b16 v[154:155], v18 offset:12288
    ds_read_b64_tr_b16 v[156:157], v19 offset:8192
    ds_read_b64_tr_b16 v[158:159], v19 offset:12288
    v_add_u32 v21, 256, v21
    v_exp_f32 v160, v160
    v_exp_f32 v161, v161
    v_exp_f32 v162, v162
    v_exp_f32 v163, v163
    s_cmp_lt_u32 s53, 3
    s_cbranch_scc1 NI_1
    s_waitcnt lgkmcnt(0)
    s_add_u32 m0, s42, 8192
    v_and_or_b32 v188, v176, s40, v4
    buffer_load_dwordx4 v188, s[4:7], 0 offen lds
    v_exp_f32 v164, v164
    v_exp_f32 v165, v165
    v_exp_f32 v166, v166
    s_add_u32 m0, m0, 1024
    v_and_or_b32 v189, v177, s40, v5
    buffer_load_dwordx4 v189, s[4:7], 0 offen lds
    v_exp_f32 v167, v167
    v_add_f32 v160, 1.0, v160
    v_add_f32 v161, 1.0, v161
    s_add_u32 m0, m0, 1024
    v_and_or_b32 v190, v178, s40, v6
    buffer_load_dwordx4 v190, s[4:7], 0 offen lds
    v_add_f32 v162, 1.0, v162
    v_add_f32 v163, 1.0, v163
    v_add_f32 v164, 1.0, v164
    s_add_u32 m0, m0, 1024
    v_and_or_b32 v191, v179, s40, v7
    buffer_load_dwordx4 v191, s[4:7], 0 offen lds
    v_add_f32 v165, 1.0, v165
    v_add_f32 v166, 1.0, v166
    v_add_f32 v167, 1.0, v167
    s_add_u32 m0, m0, 1024
    v_and_or_b32 v192, v180, s40, v4
    buffer_load_dwordx4 v192, s[4:7], 0 offen lds
    v_rcp_f32 v160, v160
    v_rcp_f32 v161, v161
    v_rcp_f32 v162, v162
    s_add_u32 m0, m0, 1024
    v_and_or_b32 v193, v181, s40, v5
    buffer_load_dwordx4 v193, s[4:7], 0 offen lds
    v_rcp_f32 v163, v163
    v_rcp_f32 v164, v164
    v_rcp_f32 v165, v165
    s_add_u32 m0, m0, 1024
    v_and_or_b32 v194, v182, s40, v6
    buffer_load_dwordx4 v194, s[4:7], 0 offen lds
    v_rcp_f32 v166, v166
    v_rcp_f32 v167, v167
    v_cndmask_b32 v160, 0, v160, s[60:61]
    s_add_u32 m0, m0, 1024
    v_and_or_b32 v195, v183, s40, v7
    buffer_load_dwordx4 v195, s[4:7], 0 offen lds
    v_cndmask_b32 v161, 0, v161, s[62:63]
    v_cndmask_b32 v162, 0, v162, s[64:65]
    v_cndmask_b32 v163, 0, v163, s[66:67]
    v_cndmask_b32 v164, 0, v164, s[68:69]
    v_cndmask_b32 v165, 0, v165, s[70:71]
    v_cndmask_b32 v166, 0, v166, s[72:73]
    v_cndmask_b32 v167, 0, v167, s[74:75]
    v_cvt_pk_bf16_f32 v184, v160, v161
    v_cvt_pk_bf16_f32 v185, v162, v163
    v_cvt_pk_bf16_f32 v186, v164, v165
    v_cvt_pk_bf16_f32 v187, v166, v167
    s_branch DI_1
NI_1:
    s_nop 1
    v_exp_f32 v164, v164
    v_exp_f32 v165, v165
    v_exp_f32 v166, v166
    v_exp_f32 v167, v167
    v_add_f32 v160, 1.0, v160
    v_add_f32 v161, 1.0, v161
    v_add_f32 v162, 1.0, v162
    v_add_f32 v163, 1.0, v163
    v_add_f32 v164, 1.0, v164
    v_add_f32 v165, 1.0, v165
    v_add_f32 v166, 1.0, v166
    v_add_f32 v167, 1.0, v167
    v_rcp_f32 v160, v160
    v_rcp_f32 v161, v161
    v_rcp_f32 v162, v162
    v_rcp_f32 v163, v163
    v_rcp_f32 v164, v164
    v_rcp_f32 v165, v165
    v_rcp_f32 v166, v166
    v_rcp_f32 v167, v167
    v_cndmask_b32 v160, 0, v160, s[60:61]
    v_cndmask_b32 v161, 0, v161, s[62:63]
    v_cndmask_b32 v162, 0, v162, s[64:65]
    v_cndmask_b32 v163, 0, v163, s[66:67]
    v_cndmask_b32 v164, 0, v164, s[68:69]
    v_cndmask_b32 v165, 0, v165, s[70:71]
    v_cndmask_b32 v166, 0, v166, s[72:73]
    v_cndmask_b32 v167, 0, v167, s[74:75]
    v_cvt_pk_bf16_f32 v184, v160, v161
    v_cvt_pk_bf16_f32 v185, v162, v163
    v_cvt_pk_bf16_f32 v186, v164, v165
    v_cvt_pk_bf16_f32 v187, v166, v167
    s_waitcnt lgkmcnt(0)
DI_1:
    s_sub_u32 s53, s53, 1
    s_cmp_eq_u32 s53, 0
    v_mfma_f32_16x16x32_bf16 v[32:35], v[128:131], v[184:187], v[32:35]
    v_mfma_f32_16x16x32_bf16 v[36:39], v[132:135], v[184:187], v[36:39]
    v_mfma_f32_16x16x32_bf16 v[40:43], v[136:139], v[184:187], v[40:43]
    v_mfma_f32_16x16x32_bf16 v[44:47], v[140:143], v[184:187], v[44:47]
    v_mfma_f32_16x16x32_bf16 v[48:51], v[144:147], v[184:187], v[48:51]
    v_mfma_f32_16x16x32_bf16 v[52:55], v[148:151], v[184:187], v[52:55]
    v_mfma_f32_16x16x32_bf16 v[56:59], v[152:155], v[184:187], v[56:59]
    v_mfma_f32_16x16x32_bf16 v[60:63], v[156:159], v[184:187], v[60:63]
    s_cbranch_scc1 L_done
    s_branch L_loop
L_done:
    s_setprio 0
    s_or_b64 s[54:55], s[76:77], s[78:79]
    s_or_b32 s54, s54, s55
    s_or_b32 s54, s54, s52
    s_cbranch_scc1 L_slow
    s_sub_u32 s50, s42, 83968
    s_lshr_b32 s51, s3, 2
    s_lshl_b32 s51, s51, 16
    s_add_u32 s51, s51, 4294901760
    v_cvt_pk_bf16_f32 v96, v32, v33
    v_cvt_pk_bf16_f32 v97, v34, v35
    v_cvt_pk_bf16_f32 v98, v36, v37
    v_cvt_pk_bf16_f32 v99, v38, v39
    v_add_u32 v2, s50, v24
    ds_write_b128 v2, v[96:99]
    v_add_u32 v236, s51, v24
    v_cvt_pk_bf16_f32 v100, v40, v41
    v_cvt_pk_bf16_f32 v101, v42, v43
    v_cvt_pk_bf16_f32 v102, v44, v45
    v_cvt_pk_bf16_f32 v103, v46, v47
    v_add_u32 v2, s50, v25
    ds_write_b128 v2, v[100:103]
    v_add_u32 v237, s51, v25
    v_cvt_pk_bf16_f32 v104, v48, v49
    v_cvt_pk_bf16_f32 v105, v50, v51
    v_cvt_pk_bf16_f32 v106, v52, v53
    v_cvt_pk_bf16_f32 v107, v54, v55
    v_add_u32 v2, s50, v26
    ds_write_b128 v2, v[104:107]
    v_add_u32 v238, s51, v26
    v_cvt_pk_bf16_f32 v108, v56, v57
    v_cvt_pk_bf16_f32 v109, v58, v59
    v_cvt_pk_bf16_f32 v110, v60, v61
    v_cvt_pk_bf16_f32 v111, v62, v63
    v_add_u32 v2, s50, v27
    ds_write_b128 v2, v[108:111]
    v_add_u32 v239, s51, v27
    v_lshlrev_b32 v1, 19, v28
    v_lshl_add_u32 v1, v29, 4, v1
    s_lshl_b32 s50, s2, 8
    s_and_b32 s51, s3, 3
    s_lshl_b32 s51, s51, 6
    s_add_u32 s50, s50, s51
    s_lshr_b32 s51, s3, 2
    s_lshl_b32 s51, s51, 18
    s_add_u32 s50, s50, s51
    v_add_u32 v1, s50, v1
    s_and_b32 s51, s3, 4
    v_mov_b32 v2, s51
    v_mov_b32 v3, 1
    s_waitcnt lgkmcnt(0)
    s_mov_b64 exec, 1
    ds_add_u32 v2, v3 offset:17540
    s_mov_b64 exec, -1
L_hb:
    ds_read_b32 v3, v2 offset:17540
    s_waitcnt lgkmcnt(0)
    v_readfirstlane_b32 s51, v3
    s_cmp_lt_u32 s51, 4
    s_cbranch_scc1 L_hb
    ds_read_b128 v[96:99], v236 offset:0
    ds_read_b128 v[100:103], v237 offset:0
    ds_read_b128 v[104:107], v238 offset:0
    ds_read_b128 v[108:111], v239 offset:0
    ds_read_b128 v[112:115], v236 offset:16384
    ds_read_b128 v[116:119], v237 offset:16384
    ds_read_b128 v[120:123], v238 offset:16384
    ds_read_b128 v[124:127], v239 offset:16384
    ds_read_b128 v[128:131], v236 offset:32768
    ds_read_b128 v[132:135], v237 offset:32768
    ds_read_b128 v[136:139], v238 offset:32768
    ds_read_b128 v[140:143], v239 offset:32768
    s_waitcnt lgkmcnt(11)
    v_mfma_f32_16x16x32_bf16 v[32:35], v[196:199], v[96:99], 0
    v_mfma_f32_16x16x32_bf16 v[36:39], v[212:215], v[96:99], 0
    ds_read_b128 v[144:147], v236 offset:49152
    s_waitcnt lgkmcnt(11)
    v_mfma_f32_16x16x32_bf16 v[32:35], v[200:203], v[100:103], v[32:35]
    v_mfma_f32_16x16x32_bf16 v[36:39], v[216:219], v[100:103], v[36:39]
    ds_read_b128 v[148:151], v237 offset:49152
    s_waitcnt lgkmcnt(11)
    v_mfma_f32_16x16x32_bf16 v[32:35], v[204:207], v[104:107], v[32:35]
    v_mfma_f32_16x16x32_bf16 v[36:39], v[220:223], v[104:107], v[36:39]
    ds_read_b128 v[152:155], v238 offset:49152
    s_waitcnt lgkmcnt(11)
    v_mfma_f32_16x16x32_bf16 v[32:35], v[208:211], v[108:111], v[32:35]
    v_mfma_f32_16x16x32_bf16 v[36:39], v[224:227], v[108:111], v[36:39]
    ds_read_b128 v[156:159], v239 offset:49152
    s_waitcnt lgkmcnt(11)
    v_mfma_f32_16x16x32_bf16 v[40:43], v[196:199], v[112:115], 0
    v_mfma_f32_16x16x32_bf16 v[44:47], v[212:215], v[112:115], 0
    s_waitcnt lgkmcnt(10)
    v_mfma_f32_16x16x32_bf16 v[40:43], v[200:203], v[116:119], v[40:43]
    v_mfma_f32_16x16x32_bf16 v[44:47], v[216:219], v[116:119], v[44:47]
    s_waitcnt lgkmcnt(9)
    v_mfma_f32_16x16x32_bf16 v[40:43], v[204:207], v[120:123], v[40:43]
    v_mfma_f32_16x16x32_bf16 v[44:47], v[220:223], v[120:123], v[44:47]
    s_waitcnt lgkmcnt(8)
    v_mfma_f32_16x16x32_bf16 v[40:43], v[208:211], v[124:127], v[40:43]
    v_mfma_f32_16x16x32_bf16 v[44:47], v[224:227], v[124:127], v[44:47]
    s_waitcnt lgkmcnt(7)
    v_mfma_f32_16x16x32_bf16 v[48:51], v[196:199], v[128:131], 0
    v_mfma_f32_16x16x32_bf16 v[52:55], v[212:215], v[128:131], 0
    s_waitcnt lgkmcnt(6)
    v_mfma_f32_16x16x32_bf16 v[48:51], v[200:203], v[132:135], v[48:51]
    v_mfma_f32_16x16x32_bf16 v[52:55], v[216:219], v[132:135], v[52:55]
    s_waitcnt lgkmcnt(5)
    v_mfma_f32_16x16x32_bf16 v[48:51], v[204:207], v[136:139], v[48:51]
    v_mfma_f32_16x16x32_bf16 v[52:55], v[220:223], v[136:139], v[52:55]
    s_waitcnt lgkmcnt(4)
    v_mfma_f32_16x16x32_bf16 v[48:51], v[208:211], v[140:143], v[48:51]
    v_mfma_f32_16x16x32_bf16 v[52:55], v[224:227], v[140:143], v[52:55]
    s_waitcnt lgkmcnt(3)
    v_mfma_f32_16x16x32_bf16 v[56:59], v[196:199], v[144:147], 0
    v_mfma_f32_16x16x32_bf16 v[60:63], v[212:215], v[144:147], 0
    s_waitcnt lgkmcnt(2)
    v_mfma_f32_16x16x32_bf16 v[56:59], v[200:203], v[148:151], v[56:59]
    v_mfma_f32_16x16x32_bf16 v[60:63], v[216:219], v[148:151], v[60:63]
    s_waitcnt lgkmcnt(1)
    v_mfma_f32_16x16x32_bf16 v[56:59], v[204:207], v[152:155], v[56:59]
    v_mfma_f32_16x16x32_bf16 v[60:63], v[220:223], v[152:155], v[60:63]
    s_waitcnt lgkmcnt(0)
    v_mfma_f32_16x16x32_bf16 v[56:59], v[208:211], v[156:159], v[56:59]
    v_mfma_f32_16x16x32_bf16 v[60:63], v[224:227], v[156:159], v[60:63]
    v_cvt_pk_bf16_f32 v96, v32, v33
    v_cvt_pk_bf16_f32 v97, v34, v35
    v_cvt_pk_bf16_f32 v98, v36, v37
    v_cvt_pk_bf16_f32 v99, v38, v39
    buffer_store_dwordx4 v[96:99], v1, s[16:19], 0 offen nt
    v_add_u32 v1, 0x10000, v1
    v_cvt_pk_bf16_f32 v100, v40, v41
    v_cvt_pk_bf16_f32 v101, v42, v43
    v_cvt_pk_bf16_f32 v102, v44, v45
    v_cvt_pk_bf16_f32 v103, v46, v47
    buffer_store_dwordx4 v[100:103], v1, s[16:19], 0 offen nt
    v_add_u32 v1, 0x10000, v1
    v_cvt_pk_bf16_f32 v104, v48, v49
    v_cvt_pk_bf16_f32 v105, v50, v51
    v_cvt_pk_bf16_f32 v106, v52, v53
    v_cvt_pk_bf16_f32 v107, v54, v55
    buffer_store_dwordx4 v[104:107], v1, s[16:19], 0 offen nt
    v_add_u32 v1, 0x10000, v1
    s_nop 4
    v_cvt_pk_bf16_f32 v108, v56, v57
    v_cvt_pk_bf16_f32 v109, v58, v59
    v_cvt_pk_bf16_f32 v110, v60, v61
    v_cvt_pk_bf16_f32 v111, v62, v63
    buffer_store_dwordx4 v[108:111], v1, s[16:19], 0 offen nt
L_end:
    s_endpgm
L_ovf:
    v_lshrrev_b32 v1, 1, v0
    v_and_b32 v1, 0xfc, v1
    ds_read_b32 v112, v1 offset:16384
    ds_read_b32 v113, v1 offset:16512
    ds_read_b32 v114, v1 offset:16640
    ds_read_b32 v115, v1 offset:16768
    ds_read_b32 v116, v1 offset:16896
    ds_read_b32 v117, v1 offset:17024
    ds_read_b32 v118, v1 offset:17152
    ds_read_b32 v119, v1 offset:17280
    s_waitcnt lgkmcnt(0)
    v_cmpx_lt_u32 vcc, 32, v112
    v_mov_b32 v128, 0x70
    v_mov_b32 v129, 0
    v_mov_b32 v130, 0
    v_mov_b32 v131, 0
    s_mov_b64 exec, -1
    v_cmpx_lt_u32 vcc, 32, v113
    v_mov_b32 v132, 0x70
    v_mov_b32 v133, 0
    v_mov_b32 v134, 0
    v_mov_b32 v135, 0
    s_mov_b64 exec, -1
    v_cmpx_lt_u32 vcc, 32, v114
    v_mov_b32 v136, 0x70
    v_mov_b32 v137, 0
    v_mov_b32 v138, 0
    v_mov_b32 v139, 0
    s_mov_b64 exec, -1
    v_cmpx_lt_u32 vcc, 32, v115
    v_mov_b32 v140, 0x70
    v_mov_b32 v141, 0
    v_mov_b32 v142, 0
    v_mov_b32 v143, 0
    s_mov_b64 exec, -1
    v_cmpx_lt_u32 vcc, 32, v116
    v_mov_b32 v144, 0x70
    v_mov_b32 v145, 0
    v_mov_b32 v146, 0
    v_mov_b32 v147, 0
    s_mov_b64 exec, -1
    v_cmpx_lt_u32 vcc, 32, v117
    v_mov_b32 v148, 0x70
    v_mov_b32 v149, 0
    v_mov_b32 v150, 0
    v_mov_b32 v151, 0
    s_mov_b64 exec, -1
    v_cmpx_lt_u32 vcc, 32, v118
    v_mov_b32 v152, 0x70
    v_mov_b32 v153, 0
    v_mov_b32 v154, 0
    v_mov_b32 v155, 0
    s_mov_b64 exec, -1
    v_cmpx_lt_u32 vcc, 32, v119
    v_mov_b32 v156, 0x70
    v_mov_b32 v157, 0
    v_mov_b32 v158, 0
    v_mov_b32 v159, 0
    s_mov_b64 exec, -1
    s_branch L_copy
L_mark:
    v_lshrrev_b32 v1, 3, v0
    v_lshlrev_b32_e64 v2, v1, 1
    v_lshrrev_b32 v1, 3, v1
    v_and_b32 v1, 4, v1
    s_mov_b64 exec, vcc
    ds_or_b32 v1, v2 offset:17520
    v_mov_b32 v228, 0
    s_mov_b64 exec, s[50:51]
    ds_or_b32 v1, v2 offset:17528
    v_mov_b32 v232, 0
    s_mov_b64 exec, -1
    s_branch L_place
L_slow:
    s_barrier
    v_mov_b32 v236, 0
    v_mov_b32 v237, 0
    v_mov_b32 v238, 0
    v_mov_b32 v239, 0
    ds_write_b128 v23, v[236:239]
    ds_write_b128 v23, v[236:239] offset:8192
    s_cmp_lg_u32 s52, 0
    s_cbranch_scc1 L_slow_go
    s_cmp_eq_u64 s[76:77], 0
    s_cbranch_scc1 L_slow_hi
    s_ff1_i32_b64 s57, s[76:77]
    s_bitset0_b64 s[76:77], s57
    s_branch L_slow_ld
L_slow_hi:
    s_ff1_i32_b64 s57, s[78:79]
    s_bitset0_b64 s[78:79], s57
    s_add_u32 s57, s57, 64
L_slow_ld:
    s_mov_b32 s12, s26
    s_and_b32 s13, s27, 0xffff
    s_mov_b32 s14, 1600000
    s_mov_b32 s15, 0x20000
    s_mul_i32 s58, s57, 12512
    s_mov_b32 s59, 391
    s_cmp_eq_u32 s57, 127
    s_cselect_b32 s59, 343, s59
    v_lshlrev_b32 v236, 5, v0
    buffer_load_dwordx4 v[104:107], v236, s[20:23], s58 offen
    buffer_load_dwordx4 v[108:111], v236, s[20:23], s58 offen offset:16
    buffer_load_dwordx4 v[96:99], v236, s[12:15], s58 offen
    buffer_load_dwordx4 v[100:103], v236, s[12:15], s58 offen offset:16
    s_waitcnt vmcnt(0)
    v_mov_b32 v237, 0x81
    v_cmp_le_u32 s[60:61], s41, v96
    v_cmp_le_u32 s[62:63], s41, v97
    v_cmp_le_u32 s[64:65], s41, v98
    v_cmp_le_u32 s[66:67], s41, v99
    v_cmp_le_u32 s[68:69], s41, v100
    v_cmp_le_u32 s[70:71], s41, v101
    v_cmp_le_u32 s[72:73], s41, v102
    v_cmp_le_u32 s[74:75], s41, v103
    v_lshrrev_b32 v238, 4, v104
    v_and_b32 v238, 0x70, v238
    v_lshl_or_b32 v228, v96, 8, v238
    v_lshrrev_b32 v238, 11, v104
    v_cndmask_b32 v239, 1, v237, s[60:61]
    v_add3_u32 v228, v228, v238, v239
    v_lshrrev_b32 v238, 4, v105
    v_and_b32 v238, 0x70, v238
    v_lshl_or_b32 v229, v97, 8, v238
    v_lshrrev_b32 v238, 11, v105
    v_cndmask_b32 v239, 1, v237, s[62:63]
    v_add3_u32 v229, v229, v238, v239
    v_lshrrev_b32 v238, 4, v106
    v_and_b32 v238, 0x70, v238
    v_lshl_or_b32 v230, v98, 8, v238
    v_lshrrev_b32 v238, 11, v106
    v_cndmask_b32 v239, 1, v237, s[64:65]
    v_add3_u32 v230, v230, v238, v239
    v_lshrrev_b32 v238, 4, v107
    v_and_b32 v238, 0x70, v238
    v_lshl_or_b32 v231, v99, 8, v238
    v_lshrrev_b32 v238, 11, v107
    v_cndmask_b32 v239, 1, v237, s[66:67]
    v_add3_u32 v231, v231, v238, v239
    v_lshrrev_b32 v238, 4, v108
    v_and_b32 v238, 0x70, v238
    v_lshl_or_b32 v232, v100, 8, v238
    v_lshrrev_b32 v238, 11, v108
    v_cndmask_b32 v239, 1, v237, s[68:69]
    v_add3_u32 v232, v232, v238, v239
    v_lshrrev_b32 v238, 4, v109
    v_and_b32 v238, 0x70, v238
    v_lshl_or_b32 v233, v101, 8, v238
    v_lshrrev_b32 v238, 11, v109
    v_cndmask_b32 v239, 1, v237, s[70:71]
    v_add3_u32 v233, v233, v238, v239
    v_lshrrev_b32 v238, 4, v110
    v_and_b32 v238, 0x70, v238
    v_lshl_or_b32 v234, v102, 8, v238
    v_lshrrev_b32 v238, 11, v110
    v_cndmask_b32 v239, 1, v237, s[72:73]
    v_add3_u32 v234, v234, v238, v239
    v_lshrrev_b32 v238, 4, v111
    v_and_b32 v238, 0x70, v238
    v_lshl_or_b32 v235, v103, 8, v238
    v_lshrrev_b32 v238, 11, v111
    v_cndmask_b32 v239, 1, v237, s[74:75]
    v_add3_u32 v235, v235, v238, v239
    v_cmp_gt_u32 s[54:55], s59, v0
    v_and_b32 v1, 0xff, v104
    v_cmp_eq_u32 vcc, s2, v1
    s_and_b64 vcc, vcc, s[54:55]
    s_nop 1
    v_cndmask_b32 v228, 0, v228, vcc
    v_and_b32 v1, 0xff, v105
    v_cmp_eq_u32 vcc, s2, v1
    s_and_b64 vcc, vcc, s[54:55]
    s_nop 1
    v_cndmask_b32 v229, 0, v229, vcc
    v_and_b32 v1, 0xff, v106
    v_cmp_eq_u32 vcc, s2, v1
    s_and_b64 vcc, vcc, s[54:55]
    s_nop 1
    v_cndmask_b32 v230, 0, v230, vcc
    v_and_b32 v1, 0xff, v107
    v_cmp_eq_u32 vcc, s2, v1
    s_and_b64 vcc, vcc, s[54:55]
    s_nop 1
    v_cndmask_b32 v231, 0, v231, vcc
    v_and_b32 v1, 0xff, v108
    v_cmp_eq_u32 vcc, s2, v1
    s_and_b64 vcc, vcc, s[54:55]
    s_nop 1
    v_cndmask_b32 v232, 0, v232, vcc
    v_and_b32 v1, 0xff, v109
    v_cmp_eq_u32 vcc, s2, v1
    s_and_b64 vcc, vcc, s[54:55]
    s_nop 1
    v_cndmask_b32 v233, 0, v233, vcc
    v_and_b32 v1, 0xff, v110
    v_cmp_eq_u32 vcc, s2, v1
    s_and_b64 vcc, vcc, s[54:55]
    s_nop 1
    v_cndmask_b32 v234, 0, v234, vcc
    v_and_b32 v1, 0xff, v111
    v_cmp_eq_u32 vcc, s2, v1
    s_and_b64 vcc, vcc, s[54:55]
    s_nop 1
    v_cndmask_b32 v235, 0, v235, vcc
L_slow_go:
    v_mov_b32 v160, s76
    v_mov_b32 v161, s77
    v_mov_b32 v162, s78
    v_mov_b32 v163, s79
    v_cmp_gt_u32 vcc, 7, v0
    s_and_saveexec_b64 s[54:55], vcc
    v_mov_b32 v236, 0
    v_mov_b32 v237, 0
    v_mov_b32 v238, 0
    v_mov_b32 v239, 0
    ds_write_b128 v23, v[236:239] offset:17408
    ds_write_b128 v22, v[160:163] offset:17520
    s_mov_b64 exec, -1
    s_waitcnt lgkmcnt(0)
    s_barrier
    s_branch L_place
.section .rodata,"a"
.p2align 6
.amdhsa_kernel standalone__kernel_systems_refs_featgraph__graph_kernel
  .amdhsa_next_free_vgpr 252
  .amdhsa_next_free_sgpr 100
  .amdhsa_accum_offset 252
  .amdhsa_group_segment_fixed_size 0
  .amdhsa_kernarg_size 64
  .amdhsa_user_sgpr_count 2
  .amdhsa_user_sgpr_kernarg_segment_ptr 1
  .amdhsa_system_sgpr_workgroup_id_x 1
.end_amdhsa_kernel
```
